```python
import torch

def _softmax(x, axis=-1):
    return torch.softmax(x, dim=axis)
def _gelu(x):
    return torch.nn.functional.gelu(x, approximate="tanh")
def _silu(x):
    return torch.nn.functional.silu(x)
def _sigmoid(x):
    return torch.sigmoid(x)
def _layernorm(x, axis=-1, eps=1e-5):
    m = x.mean(dim=axis, keepdim=True)
    v = x.var(dim=axis, keepdim=True, unbiased=False)
    return (x - m) / torch.sqrt(v + eps)
def _scatter_add(tgt, idx, src, axis=0):
    return tgt.clone().index_add_(axis, idx, src)
def _segment_sum(src, seg, n):
    out = torch.zeros((n,) + src.shape[1:], dtype=src.dtype)
    return out.index_add_(0, seg, src)
def _pad(x, pw):
    flat = tuple(v for pair in reversed(pw) for v in pair)
    return torch.nn.functional.pad(x, flat)

kernel_name = 'sequential_preLN__gqa_block_cached__mixer_channel_mlp__decode'

def setup_inputs():

    _w = (lambda a: (lambda t: t.to(torch.bfloat16) if t.is_floating_point() else t)(torch.as_tensor(a)))
    def _A_setup():
        B, Sq, D = 1, 1, 512
        Hq, Hkv, Sk, Dh = 32, 32, 4096, 128
        assert Hq % Hkv == 0, (Hq, Hkv)
        return {
            "x": _w((lambda *s: torch.randn(*s, dtype=torch.bfloat16) * 0.05)(B, Sq, D)),
            "k_cache": _w((lambda *s: torch.randn(*s, dtype=torch.bfloat16) * 3.2)(B, Hkv, Sk, Dh)),
            "v_cache": _w((lambda *s: torch.randn(*s, dtype=torch.bfloat16) * 0.4)(B, Hkv, Sk, Dh)),
            "wq": _w((lambda *s: torch.randn(*s, dtype=torch.bfloat16) * 3.2)(D, Hq * Dh) * (D ** -0.5)),
            "wo": _w((lambda *s: torch.randn(*s, dtype=torch.bfloat16) * 0.4)(Hq * Dh, D) * ((Hq * Dh) ** -0.5)),
        }
    _A_in = _A_setup()

    def _B_setup():
        B, S, D, F = 1, 1, 512, 1376
        return {
            "x": _w((lambda *s: torch.randn(*s, dtype=torch.bfloat16) * 0.05)(B, S, D)),
            "w1": _w((lambda *s: torch.randn(*s, dtype=torch.bfloat16) * 3.2)(D, F) * (D ** -0.5)),
            "b1": _w((lambda *s: torch.randn(*s, dtype=torch.bfloat16) * 1.6)(F)),
            "w2": _w((lambda *s: torch.randn(*s, dtype=torch.bfloat16) * 0.1)(F, D) * (F ** -0.5)),
            "b2": _w((lambda *s: torch.randn(*s, dtype=torch.bfloat16) * 0.1)(D)),
        }
    _B_in = _B_setup()

    return {
        "A_x": _A_in["x"],
        "A_k_cache": _A_in["k_cache"],
        "A_v_cache": _A_in["v_cache"],
        "A_wq": _A_in["wq"],
        "A_wo": _A_in["wo"],
        "B_x": _B_in["x"],
        "B_w1": _B_in["w1"],
        "B_b1": _B_in["b1"],
        "B_w2": _B_in["w2"],
        "B_b2": _B_in["b2"],
    }

def reference(A_x, A_k_cache, A_v_cache, A_wq, A_wo, B_x, B_w1, B_b1, B_w2, B_b2):
    def _A_ref(x, k_cache, v_cache, wq, wo):
        B, Sq, D = x.shape
        Hq, Dh = 32, 128
        Hkv = k_cache.shape[1]
        rep = Hq // Hkv
        q = (lambda x, *d: x.permute(*d))((x @ wq).reshape(B, Sq, Hq, Dh), 0, 2, 1, 3)
        k = (lambda x, n, axis: torch.repeat_interleave(x, n, dim=axis))(k_cache, rep, axis=1)
        v = (lambda x, n, axis: torch.repeat_interleave(x, n, dim=axis))(v_cache, rep, axis=1)
        scores = torch.einsum("bhqd,bhkd->bhqk", q, k) * (Dh ** -0.5)
        p = _softmax(scores, axis=-1)
        o = torch.einsum("bhqk,bhkd->bhqd", p, v)
        return (lambda x, *d: x.permute(*d))(o, 0, 2, 1, 3).reshape(B, Sq, Hq * Dh) @ wo

    def _B_ref(x, w1, b1, w2, b2):
        y = _layernorm(x, axis=-1)
        h = _gelu(torch.einsum("bsd,df->bsf", y, w1) + b1)
        return torch.einsum("bsf,fd->bsd", h, w2) + b2

    x = A_x
    h = x + _A_ref(_layernorm(x, axis=-1), A_k_cache, A_v_cache, A_wq, A_wo)
    h2 = h + _B_ref(_layernorm(h, axis=-1), B_w1, B_b1, B_w2, B_b2)
    return h2
```

```asm
; @launch grid=(256,1,1) block=(1024,1,1) lds=94976
.amdgcn_target "amdgcn-amd-amdhsa--gfx950"
.text
.globl sequential_preLN__gqa_block_cached__mixer_channel_mlp__decode_kernel
.p2align 8
.type sequential_preLN__gqa_block_cached__mixer_channel_mlp__decode_kernel,@function
sequential_preLN__gqa_block_cached__mixer_channel_mlp__decode_kernel:
    s_cmp_ge_u32 s2, 0x100
    s_cbranch_scc1 END0
    s_load_dwordx16 s[4:19], s[0:1], 0
    s_load_dwordx2 s[28:29], s[0:1], 96
    s_load_dwordx8 s[20:27], s[0:1], 64
    s_setprio 3
    v_lshrrev_b32 v1, 6, v0
    v_and_b32 v0, 63, v0
    v_readfirstlane_b32 s3, v1
    s_and_b32 s36, s2, 7

    s_lshr_b32 s37, s2, 3
    s_lshl_b32 s38, s36, 5
    s_or_b32 s38, s38, s37
    v_lshlrev_b32 v14, 4, v0
    s_mov_b32 s32, 13
    s_cmp_ge_u32 s3, 2
    s_cbranch_scc1 KW
    s_and_b32 s44, s38, 7
    s_lshl_b32 s45, s44, 7
    v_lshrrev_b32 v16, 3, v0
    v_and_b32 v15, 3, v0
    v_lshlrev_b32 v15, 2, v15
    v_lshl_or_b32 v15, v16, 4, v15
    v_or_b32 v15, s45, v15
    s_lshl_b32 s44, s44, 12
    s_lshr_b32 s45, s38, 3
    s_lshl1_add_u32 s44, s45, s44
    s_or_b32 s44, s44, s3
    s_lshl_b32 s44, s44, 7
    v_and_b32 v17, 0x70, v14
    v_lshl_or_b32 v96, v16, 16, v17
    v_add_u32 v96, s44, v96
    s_movk_i32 s45, 0x2000
    v_add_u32 v97, s45, v96
    v_add_u32 v98, s45, v97
    v_add_u32 v99, s45, v98
    v_add_u32 v100, s45, v99
    v_add_u32 v101, s45, v100
    v_add_u32 v102, s45, v101
    v_add_u32 v103, s45, v102
    s_waitcnt lgkmcnt(0)
    global_load_dwordx4 v[24:27], v14, s[4:5]
    global_load_dword v8, v15, s[4:5]
    global_load_dwordx4 v[64:67], v96, s[10:11] nt
    global_load_dwordx4 v[68:71], v97, s[10:11] nt
    global_load_dwordx4 v[72:75], v98, s[10:11] nt
    global_load_dwordx4 v[76:79], v99, s[10:11] nt
    global_load_dwordx4 v[80:83], v100, s[10:11] nt
    global_load_dwordx4 v[84:87], v101, s[10:11] nt
    global_load_dwordx4 v[88:91], v102, s[10:11] nt
    global_load_dwordx4 v[92:95], v103, s[10:11] nt
    s_branch QW2
KW:
    v_and_b32 v6, 0x30, v14
    v_and_b32 v7, 0xc0, v14
    v_lshl_or_b32 v6, v7, 2, v6
    v_and_b32 v4, 0x30, v0
    v_lshl_or_b32 v1, v4, 2, v6
    s_lshl_b32 s39, s38, 4
    s_or_b32 s39, s39, s3
    s_lshl_b32 s39, s39, 13
    s_or_b32 s39, s39, 0x1000
    v_add_u32 v13, s39, v1
    s_cmp_ge_u32 s3, s32
    s_waitcnt lgkmcnt(0)
    s_load_dword s41, s[28:29], 393216
    s_cbranch_scc1 SETUP
    global_load_dwordx4 v[32:35], v13, s[6:7] offset:-4096 nt
    global_load_dwordx4 v[36:39], v13, s[6:7] offset:-3072 nt
    global_load_dwordx4 v[40:43], v13, s[6:7] offset:-2048 nt
    global_load_dwordx4 v[44:47], v13, s[6:7] offset:-1024 nt
    global_load_dwordx4 v[48:51], v13, s[6:7] offset:0 nt
    global_load_dwordx4 v[52:55], v13, s[6:7] offset:1024 nt
    global_load_dwordx4 v[56:59], v13, s[6:7] offset:2048 nt
    global_load_dwordx4 v[60:63], v13, s[6:7] offset:3072 nt
SETUP:
    v_and_b32 v16, 1, v0
    v_lshlrev_b32 v16, 4, v16
    s_mov_b32 s44, 0xffff
    v_lshlrev_b32 v16, v16, s44
    v_bfe_u32 v17, v0, 1, 2
    v_cmp_eq_u32 vcc, 0, v17
    s_nop 1
    v_cndmask_b32 v9, 0, v16, vcc
    v_cmp_eq_u32 vcc, 1, v17
    s_nop 1
    v_cndmask_b32 v10, 0, v16, vcc
    v_cmp_eq_u32 vcc, 2, v17
    s_nop 1
    v_cndmask_b32 v11, 0, v16, vcc
    v_cmp_eq_u32 vcc, 3, v17
    s_nop 1
    v_cndmask_b32 v12, 0, v16, vcc
    v_and_b32 v2, 0xf0, v14
    v_lshl_or_b32 v2, v4, 6, v2
    v_add_u32 v2, s39, v2
    v_mov_b32 v3, 0xffffff00
    v_lshlrev_b32 v6, 2, v0
    v_lshlrev_b32 v7, 3, v0
    v_mov_b32 v8, 1
    s_mul_i32 s44, s3, 520
    v_add_u32 v4, s44, v7
    v_and_b32 v15, 15, v0
    v_mul_u32_u24 v5, 520, v15
    s_mov_b32 s30, 790528
    s_mov_b32 s31, 0x00020000
    s_lshl_b32 s46, s38, 9
    s_add_u32 s51, s46, 131072
    s_add_u32 s33, s46, 262144
    s_lshr_b32 s43, s38, 3
    s_lshl_b32 s43, s43, 12
    s_lshr_b32 s44, s37, 1
    s_and_b32 s44, s44, 8
    s_and_b32 s53, s37, 7
    s_or_b32 s53, s53, s44
    s_cmp_ge_u32 s3, s32
    s_cbranch_scc1 DRY
    s_waitcnt lgkmcnt(0)
    s_add_u32 s40, s41, 1
    s_and_b32 s40, s40, 0xff
    s_xor_b32 s42, s40, 1
MAIN:
    s_mov_b64 s[34:35], exec
    s_cmp_ge_u32 s3, 12
    s_cbranch_scc1 LSET
    s_setprio 0
    s_cbranch_execz G_1
    global_load_dwordx4 v[96:99], v2, s[8:9] offset:-4096 nt
    global_load_dwordx4 v[100:103], v2, s[8:9] offset:-3840 nt
    global_load_dwordx4 v[104:107], v2, s[8:9] offset:-3584 nt
    global_load_dwordx4 v[108:111], v2, s[8:9] offset:-3328 nt
G_1:
    s_cbranch_execz G_2
    global_load_dwordx4 v[112:115], v2, s[8:9] offset:0 nt
    global_load_dwordx4 v[116:119], v2, s[8:9] offset:256 nt
    global_load_dwordx4 v[120:123], v2, s[8:9] offset:512 nt
    global_load_dwordx4 v[124:127], v2, s[8:9] offset:768 nt
G_2:
    s_cmp_lg_u32 s3, 2
    s_cbranch_scc1 BQ
    s_setprio 3
    s_mov_b32 s50, 262144
    v_and_b32 v16, 16, v0
    v_and_b32 v17, 3, v0
    v_lshlrev_b32 v17, 5, v17
    v_lshl_or_b32 v16, v16, 3, v17
    v_and_b32 v17, 4, v0
    v_lshl_or_b32 v16, v17, 1, v16
    v_and_b32 v17, 0x28, v0
    v_lshrrev_b32 v17, 1, v17
    v_or_b32 v16, v16, v17
    v_mov_b64 v[20:21], 0
    v_mov_b64 v[22:23], 0
    ds_write_b128 v14, v[20:23]
    ds_write_b128 v14, v[20:23] offset:1024
    ds_write_b64 v7, v[20:21] offset:2048
QRT:
    s_cbranch_execz G_3
    buffer_load_dwordx4 v[64:67], v14, s[28:31], s43 offen offset:0 sc1
    buffer_load_dwordx4 v[68:71], v14, s[28:31], s43 offen offset:1024 sc1
    buffer_load_dwordx4 v[72:75], v14, s[28:31], s43 offen offset:2048 sc1
    buffer_load_dwordx4 v[76:79], v14, s[28:31], s43 offen offset:3072 sc1
G_3:
    s_waitcnt vmcnt(0)
    s_sub_u32 s50, s50, 1
    s_cbranch_scc1 QOK
    v_bitop3_b32 v80, v64, v65, s40 bitop3:0x7e
    v_bitop3_b32 v81, v66, v67, s40 bitop3:0x7e
    v_bitop3_b32 v82, v68, v69, s40 bitop3:0x7e
    v_bitop3_b32 v83, v70, v71, s40 bitop3:0x7e
    v_bitop3_b32 v84, v72, v73, s40 bitop3:0x7e
    v_bitop3_b32 v85, v74, v75, s40 bitop3:0x7e
    v_bitop3_b32 v86, v76, v77, s40 bitop3:0x7e
    v_bitop3_b32 v87, v78, v79, s40 bitop3:0x7e
    v_or3_b32 v88, v80, v81, v82
    v_or3_b32 v88, v88, v83, v84
    v_or3_b32 v88, v88, v85, v86
    v_or_b32 v88, v88, v87
    v_cmp_ne_u32_sdwa vcc, v88, 0 src0_sel:BYTE_0 src1_sel:DWORD
    s_cbranch_vccnz QRT
QOK:
    v_pk_add_f32 v[64:65], v[64:65], v[68:69]
    v_pk_add_f32 v[66:67], v[66:67], v[70:71]
    v_pk_add_f32 v[72:73], v[72:73], v[76:77]
    v_pk_add_f32 v[74:75], v[74:75], v[78:79]
    v_pk_add_f32 v[64:65], v[64:65], v[72:73]
    v_pk_add_f32 v[66:67], v[66:67], v[74:75]
    s_nop 1
    v_permlane32_swap_b32 v64, v66
    v_permlane32_swap_b32 v65, v67
    v_pk_add_f32 v[64:65], v[64:65], v[66:67]
    v_cvt_pk_bf16_f32 v64, v64, v65
    ds_write_b32 v16, v64 offset:768
    s_waitcnt lgkmcnt(0)
    s_setprio 0
BQ:
    s_cbranch_execz G_4
    s_barrier
G_4:
    ds_read_b128 v[64:67], v1 offset:768
    ds_read_b128 v[68:71], v1 offset:512
    ds_read_b128 v[72:75], v1 offset:256
    ds_read_b128 v[76:79], v1 offset:0
    s_waitcnt vmcnt(8) lgkmcnt(0)
    v_mfma_f32_16x16x32_bf16 v[24:27], v[64:67], v[32:35], 0
    v_mfma_f32_16x16x32_bf16 v[28:31], v[64:67], v[48:51], 0
    v_mfma_f32_16x16x32_bf16 v[24:27], v[68:71], v[36:39], v[24:27]
    v_mfma_f32_16x16x32_bf16 v[28:31], v[68:71], v[52:55], v[28:31]
    v_mfma_f32_16x16x32_bf16 v[24:27], v[72:75], v[40:43], v[24:27]
    v_mfma_f32_16x16x32_bf16 v[28:31], v[72:75], v[56:59], v[28:31]
    v_mfma_f32_16x16x32_bf16 v[24:27], v[76:79], v[44:47], v[24:27]
    v_mfma_f32_16x16x32_bf16 v[28:31], v[76:79], v[60:63], v[28:31]
    s_nop 6
    v_mov_b32_dpp v16, v24 quad_perm:[0,0,0,0] row_mask:0xf bank_mask:0xf
    v_mov_b32_dpp v17, v28 quad_perm:[0,0,0,0] row_mask:0xf bank_mask:0xf
    s_nop 0
    v_add_f32_dpp v16, v25, v16 quad_perm:[1,1,1,1] row_mask:0xf bank_mask:0xf
    v_add_f32_dpp v17, v29, v17 quad_perm:[1,1,1,1] row_mask:0xf bank_mask:0xf
    s_nop 0
    v_add_f32_dpp v16, v26, v16 quad_perm:[2,2,2,2] row_mask:0xf bank_mask:0xf
    v_add_f32_dpp v17, v30, v17 quad_perm:[2,2,2,2] row_mask:0xf bank_mask:0xf
    s_nop 0
    v_add_f32_dpp v16, v27, v16 quad_perm:[3,3,3,3] row_mask:0xf bank_mask:0xf
    v_add_f32_dpp v17, v31, v17 quad_perm:[3,3,3,3] row_mask:0xf bank_mask:0xf
    v_cvt_pk_bf16_f32 v16, 0, v16
    v_cvt_pk_bf16_f32 v17, 0, v17
    v_mul_f32 v16, 0x3db504f3, v16
    v_mul_f32 v17, 0x3db504f3, v17
    v_cvt_pk_bf16_f32 v16, 0, v16
    v_cvt_pk_bf16_f32 v17, 0, v17
    v_max_f32 v20, v16, v17
    s_nop 1
    v_max_f32_dpp v20, v20, v20 row_ror:4 row_mask:0xf bank_mask:0xf
    s_nop 1
    v_max_f32_dpp v20, v20, v20 row_ror:8 row_mask:0xf bank_mask:0xf
    s_nop 1
    v_max_f32_dpp v20, v20, v20 row_bcast:15 row_mask:0xa bank_mask:0xf
    s_nop 1
    v_max_f32_dpp v20, v20, v20 row_bcast:31 row_mask:0xc bank_mask:0xf
    s_nop 0
    v_readlane_b32 s44, v20, 63
    s_nop 1
    v_subrev_f32 v16, s44, v16
    v_subrev_f32 v17, s44, v17
    v_mul_f32 v16, 0x3fb8aa3b, v16
    v_mul_f32 v17, 0x3fb8aa3b, v17
    v_exp_f32 v16, v16
    v_exp_f32 v17, v17
    s_nop 0
    v_add_f32 v21, v16, v17
    s_nop 1
    v_add_f32_dpp v21, v21, v21 row_ror:4 row_mask:0xf bank_mask:0xf
    s_nop 1
    v_add_f32_dpp v21, v21, v21 row_ror:8 row_mask:0xf bank_mask:0xf
    s_nop 1
    v_add_f32_dpp v21, v21, v21 row_bcast:15 row_mask:0xa bank_mask:0xf
    s_nop 1
    v_add_f32_dpp v21, v21, v21 row_bcast:31 row_mask:0xc bank_mask:0xf
    ds_write_b64 v4, v[20:21] offset:6656
    s_cmp_lt_u32 s3, 12
    s_waitcnt lgkmcnt(0)
    s_cmp_lt_u32 s3, 12
    s_cbranch_scc1 WIS
    v_mov_b32 v32, v2
    v_add_u32 v36, s56, v32
    v_add_u32 v40, s56, v36
    v_add_u32 v44, s56, v40
    v_add_u32 v48, s56, v44
    v_add_u32 v52, s56, v48
    v_add_u32 v56, s56, v52
    v_add_u32 v60, s56, v56
    s_cmp_ge_u32 s52, 3
    s_cbranch_scc1 WPL
    s_cbranch_execz G_5
    global_load_dwordx4 v[32:35], v32, s[54:55] nt
    global_load_dwordx4 v[36:39], v36, s[54:55] nt
    global_load_dwordx4 v[40:43], v40, s[54:55] nt
    global_load_dwordx4 v[44:47], v44, s[54:55] nt
G_5:
    s_cbranch_execz G_6
    global_load_dwordx4 v[48:51], v48, s[54:55] nt
    global_load_dwordx4 v[52:55], v52, s[54:55] nt
    global_load_dwordx4 v[56:59], v56, s[54:55] nt
    global_load_dwordx4 v[60:63], v60, s[54:55] nt
G_6:
WIS:
    s_cmp_lt_u32 s3, 12
    s_cbranch_execz G_7
    s_barrier
G_7:
    ds_read_b64 v[18:19], v5 offset:7160
    s_cbranch_scc1 NOV
NOV:
    s_waitcnt lgkmcnt(0)
    v_max_f32_dpp v20, v18, v18 quad_perm:[1,0,3,2] row_mask:0xf bank_mask:0xf
    s_nop 1
    v_max_f32_dpp v20, v20, v20 quad_perm:[2,3,0,1] row_mask:0xf bank_mask:0xf
    s_nop 1
    v_max_f32_dpp v20, v20, v20 row_half_mirror row_mask:0xf bank_mask:0xf
    s_nop 1
    v_max_f32_dpp v20, v20, v20 row_mirror row_mask:0xf bank_mask:0xf
    v_sub_f32 v21, s44, v20
    v_mul_f32 v21, 0x3fb8aa3b, v21
    v_exp_f32 v21, v21
    s_nop 0
    v_mul_f32 v16, v21, v16
    v_mul_f32 v17, v21, v17
    v_cvt_pk_bf16_f32 v16, v16, v16
    v_cvt_pk_bf16_f32 v17, v17, v17
    s_nop 0
    v_and_b32_dpp v64, v16, v9 row_newbcast:0 row_mask:0xf bank_mask:0xf
    v_and_b32_dpp v65, v16, v10 row_newbcast:0 row_mask:0xf bank_mask:0xf
    v_and_b32_dpp v66, v16, v11 row_newbcast:0 row_mask:0xf bank_mask:0xf
    v_and_b32_dpp v67, v16, v12 row_newbcast:0 row_mask:0xf bank_mask:0xf
    v_and_b32_dpp v68, v16, v9 row_newbcast:4 row_mask:0xf bank_mask:0xf
    v_and_b32_dpp v69, v16, v10 row_newbcast:4 row_mask:0xf bank_mask:0xf
    v_and_b32_dpp v70, v16, v11 row_newbcast:4 row_mask:0xf bank_mask:0xf
    v_and_b32_dpp v71, v16, v12 row_newbcast:4 row_mask:0xf bank_mask:0xf
    v_and_b32_dpp v72, v16, v9 row_newbcast:8 row_mask:0xf bank_mask:0xf
    v_and_b32_dpp v73, v16, v10 row_newbcast:8 row_mask:0xf bank_mask:0xf
    v_and_b32_dpp v74, v16, v11 row_newbcast:8 row_mask:0xf bank_mask:0xf
    v_and_b32_dpp v75, v16, v12 row_newbcast:8 row_mask:0xf bank_mask:0xf
    v_and_b32_dpp v76, v16, v9 row_newbcast:12 row_mask:0xf bank_mask:0xf
    v_and_b32_dpp v77, v16, v10 row_newbcast:12 row_mask:0xf bank_mask:0xf
    v_and_b32_dpp v78, v16, v11 row_newbcast:12 row_mask:0xf bank_mask:0xf
    v_and_b32_dpp v79, v16, v12 row_newbcast:12 row_mask:0xf bank_mask:0xf
    v_and_b32_dpp v80, v17, v9 row_newbcast:0 row_mask:0xf bank_mask:0xf
    v_and_b32_dpp v81, v17, v10 row_newbcast:0 row_mask:0xf bank_mask:0xf
    v_and_b32_dpp v82, v17, v11 row_newbcast:0 row_mask:0xf bank_mask:0xf
    v_and_b32_dpp v83, v17, v12 row_newbcast:0 row_mask:0xf bank_mask:0xf
    v_and_b32_dpp v84, v17, v9 row_newbcast:4 row_mask:0xf bank_mask:0xf
    v_and_b32_dpp v85, v17, v10 row_newbcast:4 row_mask:0xf bank_mask:0xf
    v_and_b32_dpp v86, v17, v11 row_newbcast:4 row_mask:0xf bank_mask:0xf
    v_and_b32_dpp v87, v17, v12 row_newbcast:4 row_mask:0xf bank_mask:0xf
    v_and_b32_dpp v88, v17, v9 row_newbcast:8 row_mask:0xf bank_mask:0xf
    v_and_b32_dpp v89, v17, v10 row_newbcast:8 row_mask:0xf bank_mask:0xf
    v_and_b32_dpp v90, v17, v11 row_newbcast:8 row_mask:0xf bank_mask:0xf
    v_and_b32_dpp v91, v17, v12 row_newbcast:8 row_mask:0xf bank_mask:0xf
    v_and_b32_dpp v92, v17, v9 row_newbcast:12 row_mask:0xf bank_mask:0xf
    v_and_b32_dpp v93, v17, v10 row_newbcast:12 row_mask:0xf bank_mask:0xf
    v_and_b32_dpp v94, v17, v11 row_newbcast:12 row_mask:0xf bank_mask:0xf
    v_and_b32_dpp v95, v17, v12 row_newbcast:12 row_mask:0xf bank_mask:0xf
    s_cbranch_scc1 EPV
    s_cbranch_execz G_8
    s_barrier
G_8:
    ds_read_b64 v[16:17], v4 offset:12896
    ds_read_b64 v[18:19], v4 offset:10816
    ds_read_b64 v[20:21], v4 offset:8736
    v_add_u32 v13, 131072, v22
    s_waitcnt lgkmcnt(0)
    v_pk_add_f32 v[16:17], v[16:17], v[18:19]
    v_pk_add_f32 v[24:25], v[16:17], v[20:21]
    v_pk_add_f32 v[26:27], v[16:17], v[20:21]
    v_mov_b32 v16, s42
    v_mov_b32 v17, s42
    s_cmp_lg_u32 s52, 3
    s_cbranch_scc1 WHAS
    s_waitcnt vmcnt(0)
WHAS:
    s_waitcnt vmcnt(15)
    v_mfma_f32_16x16x32_bf16 v[24:27], v[64:67], v[96:99], v[24:27]
    s_waitcnt vmcnt(14)
    v_mfma_f32_16x16x32_bf16 v[24:27], v[68:71], v[100:103], v[24:27]
    s_waitcnt vmcnt(13)
    v_mfma_f32_16x16x32_bf16 v[24:27], v[72:75], v[104:107], v[24:27]
    s_waitcnt vmcnt(12)
    v_mfma_f32_16x16x32_bf16 v[24:27], v[76:79], v[108:111], v[24:27]
    v_mov_b64 v[64:65], v[16:17]
    v_mov_b64 v[66:67], v[16:17]
    v_mov_b64 v[68:69], v[16:17]
    v_mov_b64 v[70:71], v[16:17]
    s_waitcnt vmcnt(11)
    v_mfma_f32_16x16x32_bf16 v[24:27], v[80:83], v[112:115], v[24:27]
    s_waitcnt vmcnt(10)
    v_mfma_f32_16x16x32_bf16 v[24:27], v[84:87], v[116:119], v[24:27]
    s_waitcnt vmcnt(9)
    v_mfma_f32_16x16x32_bf16 v[24:27], v[88:91], v[120:123], v[24:27]
    s_waitcnt vmcnt(8)
    v_mfma_f32_16x16x32_bf16 v[24:27], v[92:95], v[124:127], v[24:27]
    s_cbranch_execz G_9
    buffer_load_dwordx4 v[28:31], v6, s[28:31], s58 offen sc1
G_9:
    s_nop 5
    v_mov_b32_dpp v24, v26 quad_perm:[0,1,2,3] row_mask:0xc bank_mask:0xf
    v_mov_b32_dpp v25, v27 quad_perm:[0,1,2,3] row_mask:0xc bank_mask:0xf
    ds_write_b64 v23, v[24:25] offset:2560
    s_mov_b64 exec, s[48:49]
    ds_add_rtn_u32 v26, v7, v8 offset:2048
    s_mov_b64 exec, s[34:35]
    ds_read2st64_b64 v[72:75], v7 offset0:5 offset1:6
    ds_read2st64_b64 v[76:79], v7 offset0:7 offset1:8
    s_waitcnt lgkmcnt(2)
    v_readfirstlane_b32 s44, v26
    s_waitcnt lgkmcnt(1)
    v_pk_add_f32 v[72:73], v[72:73], v[74:75]
    s_cmp_lt_u32 s44, s47
    s_cbranch_scc1 NL_10
    s_waitcnt lgkmcnt(0)
    v_pk_add_f32 v[76:77], v[76:77], v[78:79]
    v_pk_add_f32 v[24:25], v[72:73], v[76:77]
    v_and_or_b32 v24, v24, v3, s40
    v_and_or_b32 v25, v25, v3, s40
    s_cbranch_execz G_12
    buffer_store_dwordx2 v[24:25], v7, s[28:31], s51 offen
    buffer_store_dwordx2 v[24:25], v7, s[28:31], s33 offen sc1
G_12:
    s_bitcmp1_b32 s37, 3
    s_cbranch_scc1 LEND
    s_waitcnt vmcnt(2)
    s_branch DN_11
NL_10:
    s_bitcmp1_b32 s37, 3
    s_cbranch_scc1 LEND
    s_waitcnt vmcnt(0) lgkmcnt(0)
DN_11:
    s_mov_b32 s50, 262144
LA:
    v_bitop3_b32 v72, v28, v29, s40 bitop3:0x7e
    v_bitop3_b32 v73, v30, v31, s40 bitop3:0x7e
    v_or_b32 v74, v72, v73
    v_cmp_ne_u32_sdwa vcc, v74, 0 src0_sel:BYTE_0 src1_sel:DWORD
    s_cbranch_vccnz LAR
LAX:
    v_cmp_eq_u32 vcc, s45, v30
    v_and_b32 v28, v28, v3
    s_nop 0
    v_cndmask_b32 v22, v13, v22, vcc
    s_cbranch_execz G_13
    buffer_load_dwordx4 v[64:67], v22, s[28:31], s57 offen offset:0 sc1
    buffer_load_dwordx4 v[68:71], v22, s[28:31], s57 offen offset:128 sc1
G_13:
    v_max_f32_dpp v72, v28, v28 row_half_mirror row_mask:0xf bank_mask:0xf
    s_nop 1
    v_max_f32_dpp v72, v72, v72 row_bcast:15 row_mask:0xa bank_mask:0xf
    s_nop 1
    v_max_f32_dpp v72, v72, v72 row_bcast:31 row_mask:0xc bank_mask:0xf
    s_nop 0
    v_readlane_b32 s44, v72, 63
    s_nop 1
    v_subrev_f32 v28, s44, v28
    v_mul_f32 v28, 0x3fb8aa3b, v28
    v_exp_f32 v28, v28
    s_nop 0
    v_mul_f32 v29, v28, v29
    s_nop 1
    v_add_f32_dpp v29, v29, v29 row_half_mirror row_mask:0xf bank_mask:0xf
    s_nop 1
    v_add_f32_dpp v29, v29, v29 row_bcast:15 row_mask:0xa bank_mask:0xf
    s_nop 1
    v_add_f32_dpp v29, v29, v29 row_bcast:31 row_mask:0xc bank_mask:0xf
    s_nop 0
    v_readlane_b32 s44, v29, 63
    s_nop 1
    v_rcp_f32 v29, s44
    s_nop 0
    v_mul_f32 v28, v28, v29
    v_and_b32 v13, 0x17f, v7
    s_mov_b32 s50, 262144
    s_cbranch_execnz CK_15
RT_14:
    v_or_b32 v76, v72, v73
    v_cmp_ne_u32_sdwa vcc, v76, 0 src0_sel:BYTE_0 src1_sel:DWORD
    s_cbranch_vccz SK_17
    s_mov_b64 exec, vcc
    buffer_load_dwordx4 v[64:67], v22, s[28:31], s57 offen offset:0 sc1
    s_mov_b64 exec, s[34:35]
SK_17:
    v_or_b32 v76, v74, v75
    v_cmp_ne_u32_sdwa vcc, v76, 0 src0_sel:BYTE_0 src1_sel:DWORD
    s_cbranch_vccz SK_18
    s_mov_b64 exec, vcc
    buffer_load_dwordx4 v[68:71], v22, s[28:31], s57 offen offset:128 sc1
    s_mov_b64 exec, s[34:35]
SK_18:
    s_waitcnt vmcnt(5)
    s_sub_u32 s50, s50, 1
    s_cbranch_scc1 OK_16
CK_15:
    v_bitop3_b32 v72, v64, v65, s40 bitop3:0x7e
    v_bitop3_b32 v73, v66, v67, s40 bitop3:0x7e
    v_bitop3_b32 v74, v68, v69, s40 bitop3:0x7e
    v_bitop3_b32 v75, v70, v71, s40 bitop3:0x7e
    v_or3_b32 v76, v72, v73, v74
    v_or_b32 v76, v76, v75
    v_cmp_ne_u32_sdwa vcc, v76, 0 src0_sel:BYTE_0 src1_sel:DWORD
    s_cbranch_vccnz RT_14
OK_16:
    v_pk_mul_f32 v[80:81], v[64:65], v[28:29] op_sel_hi:[1,0]
    v_pk_mul_f32 v[82:83], v[66:67], v[28:29] op_sel_hi:[1,0]
    v_pk_mul_f32 v[84:85], v[68:69], v[28:29] op_sel_hi:[1,0]
    v_pk_mul_f32 v[86:87], v[70:71], v[28:29] op_sel_hi:[1,0]
    v_permlane32_swap_b32 v80, v82
    v_permlane32_swap_b32 v81, v83
    v_permlane32_swap_b32 v84, v86
    v_permlane32_swap_b32 v85, v87
    v_pk_add_f32 v[80:81], v[80:81], v[82:83]
    v_pk_add_f32 v[84:85], v[84:85], v[86:87]
    s_nop 0
    v_permlane16_swap_b32 v80, v81
    v_permlane16_swap_b32 v84, v85
    v_add_f32 v80, v80, v81
    v_add_f32 v84, v84, v85
    s_nop 0
    v_add_f32_dpp v80, v80, v80 row_half_mirror row_mask:0xf bank_mask:0xf
    v_add_f32_dpp v84, v84, v84 row_half_mirror row_mask:0xf bank_mask:0xf
    v_cvt_pk_bf16_f32 v80, v80, v80
    v_cvt_pk_bf16_f32 v84, v84, v84
    s_nop 0
    v_and_b32_dpp v96, v80, v9 quad_perm:[0,0,0,0] row_mask:0xf bank_mask:0xf
    v_and_b32_dpp v97, v80, v10 quad_perm:[0,0,0,0] row_mask:0xf bank_mask:0xf
    v_and_b32_dpp v98, v80, v11 quad_perm:[3,3,3,3] row_mask:0xf bank_mask:0xf
    v_and_b32_dpp v99, v80, v12 quad_perm:[3,3,3,3] row_mask:0xf bank_mask:0xf
    v_and_b32_dpp v100, v80, v9 quad_perm:[1,1,1,1] row_mask:0xf bank_mask:0xf
    v_and_b32_dpp v101, v80, v10 quad_perm:[1,1,1,1] row_mask:0xf bank_mask:0xf
    v_and_b32_dpp v102, v80, v11 quad_perm:[2,2,2,2] row_mask:0xf bank_mask:0xf
    v_and_b32_dpp v103, v80, v12 quad_perm:[2,2,2,2] row_mask:0xf bank_mask:0xf
    v_mfma_f32_16x16x32_bf16 v[24:27], v[96:99], v[32:35], 0
    v_and_b32_dpp v104, v80, v9 quad_perm:[2,2,2,2] row_mask:0xf bank_mask:0xf
    v_and_b32_dpp v105, v80, v10 quad_perm:[2,2,2,2] row_mask:0xf bank_mask:0xf
    v_and_b32_dpp v106, v80, v11 quad_perm:[1,1,1,1] row_mask:0xf bank_mask:0xf
    v_and_b32_dpp v107, v80, v12 quad_perm:[1,1,1,1] row_mask:0xf bank_mask:0xf
    v_mfma_f32_16x16x32_bf16 v[24:27], v[100:103], v[36:39], v[24:27]
    v_and_b32_dpp v108, v80, v9 quad_perm:[3,3,3,3] row_mask:0xf bank_mask:0xf
    v_and_b32_dpp v109, v80, v10 quad_perm:[3,3,3,3] row_mask:0xf bank_mask:0xf
    v_and_b32_dpp v110, v80, v11 quad_perm:[0,0,0,0] row_mask:0xf bank_mask:0xf
    v_and_b32_dpp v111, v80, v12 quad_perm:[0,0,0,0] row_mask:0xf bank_mask:0xf
    v_mfma_f32_16x16x32_bf16 v[24:27], v[104:107], v[40:43], v[24:27]
    v_and_b32_dpp v112, v84, v9 quad_perm:[0,0,0,0] row_mask:0xf bank_mask:0xf
    v_and_b32_dpp v113, v84, v10 quad_perm:[0,0,0,0] row_mask:0xf bank_mask:0xf
    v_and_b32_dpp v114, v84, v11 quad_perm:[3,3,3,3] row_mask:0xf bank_mask:0xf
    v_and_b32_dpp v115, v84, v12 quad_perm:[3,3,3,3] row_mask:0xf bank_mask:0xf
    v_mfma_f32_16x16x32_bf16 v[24:27], v[108:111], v[44:47], v[24:27]
    v_and_b32_dpp v116, v84, v9 quad_perm:[1,1,1,1] row_mask:0xf bank_mask:0xf
    v_and_b32_dpp v117, v84, v10 quad_perm:[1,1,1,1] row_mask:0xf bank_mask:0xf
    v_and_b32_dpp v118, v84, v11 quad_perm:[2,2,2,2] row_mask:0xf bank_mask:0xf
    v_and_b32_dpp v119, v84, v12 quad_perm:[2,2,2,2] row_mask:0xf bank_mask:0xf
    v_mfma_f32_16x16x32_bf16 v[24:27], v[112:115], v[48:51], v[24:27]
    v_and_b32_dpp v120, v84, v9 quad_perm:[2,2,2,2] row_mask:0xf bank_mask:0xf
    v_and_b32_dpp v121, v84, v10 quad_perm:[2,2,2,2] row_mask:0xf bank_mask:0xf
    v_and_b32_dpp v122, v84, v11 quad_perm:[1,1,1,1] row_mask:0xf bank_mask:0xf
    v_and_b32_dpp v123, v84, v12 quad_perm:[1,1,1,1] row_mask:0xf bank_mask:0xf
    v_mfma_f32_16x16x32_bf16 v[24:27], v[116:119], v[52:55], v[24:27]
    v_and_b32_dpp v124, v84, v9 quad_perm:[3,3,3,3] row_mask:0xf bank_mask:0xf
    v_and_b32_dpp v125, v84, v10 quad_perm:[3,3,3,3] row_mask:0xf bank_mask:0xf
    v_and_b32_dpp v126, v84, v11 quad_perm:[0,0,0,0] row_mask:0xf bank_mask:0xf
    v_and_b32_dpp v127, v84, v12 quad_perm:[0,0,0,0] row_mask:0xf bank_mask:0xf
    v_mfma_f32_16x16x32_bf16 v[24:27], v[120:123], v[56:59], v[24:27]
    s_nop 0
    v_mfma_f32_16x16x32_bf16 v[24:27], v[124:127], v[60:63], v[24:27]
    s_nop 7
    v_permlane32_swap_b32 v24, v26
    v_permlane32_swap_b32 v25, v27
    s_nop 0
    v_add_f32_dpp v24, v26, v24 row_ror:8 row_mask:0xf bank_mask:0xf
    v_add_f32_dpp v25, v27, v25 row_ror:8 row_mask:0xf bank_mask:0xf
    ds_write_b64 v23, v[24:25] offset:4608
    s_mov_b64 exec, s[48:49]
    ds_add_rtn_u32 v26, v7, v8 offset:2052
    s_mov_b64 exec, s[34:35]
    ds_read2st64_b64 v[72:75], v13 offset0:9 offset1:10
    ds_read2st64_b64 v[76:79], v13 offset0:11 offset1:12
    s_waitcnt lgkmcnt(2)
    v_readfirstlane_b32 s44, v26
    s_waitcnt lgkmcnt(1)
    v_pk_add_f32 v[72:73], v[72:73], v[74:75]
    s_cmp_lt_u32 s44, s47
    s_cbranch_scc1 DN_20
    s_waitcnt lgkmcnt(0)
    v_pk_add_f32 v[76:77], v[76:77], v[78:79]
    v_pk_add_f32 v[24:25], v[72:73], v[76:77]
    v_and_or_b32 v24, v24, v3, s40
    v_and_or_b32 v25, v25, v3, s40
    s_cbranch_execz G_21
    buffer_store_dwordx2 v[24:25], v15, s[28:31], s59 offen sc1
    buffer_store_dwordx2 v[24:25], v15, s[28:31], s92 offen sc1
    buffer_store_dwordx2 v[24:25], v15, s[28:31], s93 offen sc1
    buffer_store_dwordx2 v[24:25], v15, s[28:31], s94 offen sc1
G_21:
DN_20:
    s_branch END
LSET:
    s_setprio 0
    s_cbranch_execz G_22
    global_load_dwordx4 v[96:99], v2, s[8:9] offset:-4096 nt
    global_load_dwordx4 v[100:103], v2, s[8:9] offset:-3840 nt
    global_load_dwordx4 v[104:107], v2, s[8:9] offset:-3584 nt
    global_load_dwordx4 v[108:111], v2, s[8:9] offset:-3328 nt
G_22:
    s_cbranch_execz G_23
    global_load_dwordx4 v[112:115], v2, s[8:9] offset:0 nt
    global_load_dwordx4 v[116:119], v2, s[8:9] offset:256 nt
    global_load_dwordx4 v[120:123], v2, s[8:9] offset:512 nt
    global_load_dwordx4 v[124:127], v2, s[8:9] offset:768 nt
G_23:
    s_setprio 3
    s_and_b64 s[48:49], s[34:35], 1
    s_and_b32 s47, s34, 3
    v_and_b32 v7, 0x138, v7
    s_movk_i32 s44, 0x80
    v_and_or_b32 v7, v14, s44, v7
    v_and_or_b32 v7, v6, 64, v7
    s_and_b32 s44, s3, 3
    v_lshl_or_b32 v23, s44, 9, v7
    s_lshr_b32 s45, s37, 4
    s_xor_b32 s45, s45, 1
    s_lshl1_add_u32 s45, s36, s45
    s_lshl_b32 s59, s45, 8
    s_lshl2_add_u32 s45, s45, s44
    s_and_b32 s56, s45, 1
    s_lshr_b32 s45, s45, 1
    s_lshl_b32 s58, s45, 10
    s_add_u32 s58, s58, 397312
    s_lshl4_add_u32 s57, s45, s56
    s_lshl_b32 s57, s57, 8
    s_add_u32 s57, s57, 131072
    s_mov_b32 s52, s37
    s_and_b32 s52, s52, 7
    s_lshl_b32 s45, s45, 10
    s_lshl4_add_u32 s45, s56, s45
    s_or_b32 s45, s45, s52
    s_lshl_b32 s45, s45, 7
    s_lshl_b32 s52, s52, 12
    s_add_u32 s59, s59, s52
    s_add_u32 s59, s59, 528384
    v_bfe_u32 v18, v0, 2, 1
    v_lshrrev_b32 v6, 4, v0
    v_lshl_or_b32 v6, v6, 1, v18
    v_lshlrev_b32 v6, 7, v6
    v_mul_u32_u24 v18, 48, v18
    v_and_b32 v19, 0x30, v14
    v_xor_b32 v18, v18, v19
    v_and_b32 v17, 8, v0
    v_lshl_or_b32 v18, v17, 3, v18
    v_lshl_or_b32 v22, v6, 2, v18
    s_add_u32 s92, s59, 0x10000
    s_add_u32 s93, s59, 0x20000
    s_add_u32 s94, s59, 0x30000
    v_and_b32 v15, 0x30, v0
    v_and_b32 v16, 7, v0
    v_lshlrev_b32 v16, 3, v16
    v_lshl_or_b32 v15, v15, 2, v16
    v_and_b32 v16, 8, v0
    v_lshl_or_b32 v15, v16, 12, v15
    v_and_b32 v13, 0x70, v14
    v_lshl_or_b32 v13, v17, 9, v13
    v_and_b32 v18, 32, v0
    v_lshl_or_b32 v13, v18, 8, v13
    v_and_b32 v18, 16, v0
    v_lshl_or_b32 v13, v18, 6, v13
    s_mov_b64 s[54:55], s[12:13]
    s_movk_i32 s56, 0x4000
    s_mov_b32 s52, 0

    s_bitcmp0_b32 s37, 3
    s_cbranch_scc1 LSX
    s_mov_b32 s52, 3
    s_cmp_ge_u32 s53, 14
    s_cbranch_scc1 LNONE
    s_cmp_ge_u32 s53, 6
    s_cbranch_scc1 LPF
    s_mul_i32 s45, s36, 6
    s_add_u32 s45, s45, s53
    s_cmp_ge_u32 s45, 43
    s_cbranch_scc1 LNONE
    s_mov_b32 s52, 2
    s_mov_b64 s[54:55], s[20:21]
    s_movk_i32 s56, 0x80
    s_lshl2_add_u32 s45, s45, s44
    s_lshl_b32 s45, s45, 13
    v_lshrrev_b32 v18, 3, v0
    v_and_b32 v13, 0x70, v14
    v_lshl_or_b32 v13, v18, 10, v13
LSX:
    v_add_u32 v2, s45, v13
LDONE:
LNONE:
    s_getreg_b32 s45, hwreg(HW_REG_XCC_ID)
    s_lshl_b32 s45, s45, 8
    s_or_b32 s45, s45, s40
    s_branch BQ
LPF:
    s_sub_u32 s45, s53, 6
    s_lshl2_add_u32 s45, s45, s44
    s_mul_i32 s45, s45, 5504
    s_mul_i32 s56, s36, 384
    s_add_u32 s45, s45, s56
    s_cmp_eq_u32 s36, 7
    s_cselect_b32 s56, 48, 368
    v_and_b32 v13, 0x1f0, v14
    v_min_u32 v13, s56, v13
    v_lshrrev_b32 v18, 5, v0
    v_mul_u32_u24 v18, 2752, v18
    v_add3_u32 v2, v13, v18, s45
    s_mov_b64 s[54:55], s[16:17]
    s_mov_b32 s52, 4
    s_mov_b32 s56, 176128
    s_branch LDONE
LEND:
    s_cmp_lg_u32 s52, 2
    s_cbranch_scc1 BEND
    s_and_b32 s44, s3, 3
    s_mul_i32 s44, s44, 1088
    s_add_u32 s44, s44, 60160
    v_add_u32 v13, s44, v14
    s_waitcnt vmcnt(0)
    ds_write_b128 v13, v[32:35] offset:0
    ds_write_b128 v13, v[36:39] offset:4352
    ds_write_b128 v13, v[40:43] offset:8704
    ds_write_b128 v13, v[44:47] offset:13056
    ds_write_b128 v13, v[48:51] offset:17408
    ds_write_b128 v13, v[52:55] offset:21760
    ds_write_b128 v13, v[56:59] offset:26112
    ds_write_b128 v13, v[60:63] offset:30464
    s_waitcnt lgkmcnt(0)
    s_branch BEND
EPV:
    s_waitcnt vmcnt(7)
    v_mfma_f32_16x16x32_bf16 v[24:27], v[64:67], v[96:99], 0
    s_waitcnt vmcnt(6)
    v_mfma_f32_16x16x32_bf16 v[24:27], v[68:71], v[100:103], v[24:27]
    s_waitcnt vmcnt(5)
    v_mfma_f32_16x16x32_bf16 v[24:27], v[72:75], v[104:107], v[24:27]
    s_waitcnt vmcnt(4)
    v_mfma_f32_16x16x32_bf16 v[24:27], v[76:79], v[108:111], v[24:27]
    s_waitcnt vmcnt(3)
    v_mfma_f32_16x16x32_bf16 v[24:27], v[80:83], v[112:115], v[24:27]
    s_waitcnt vmcnt(2)
    v_mfma_f32_16x16x32_bf16 v[24:27], v[84:87], v[116:119], v[24:27]
    s_waitcnt vmcnt(1)
    v_mfma_f32_16x16x32_bf16 v[24:27], v[88:91], v[120:123], v[24:27]
    s_waitcnt vmcnt(0)
    v_mfma_f32_16x16x32_bf16 v[24:27], v[92:95], v[124:127], v[24:27]
    s_mov_b32 s52, 3
    s_cmp_lg_u32 s3, 2
    s_cbranch_scc1 NOML
    v_sub_f32 v18, v18, v20
    v_mul_f32 v18, 0x3fb8aa3b, v18
    v_exp_f32 v18, v18
    s_getreg_b32 s44, hwreg(HW_REG_XCC_ID)
    s_lshl_b32 s44, s44, 8
    v_mul_f32 v21, v18, v19
    v_mov_b32 v22, s44
    v_mov_b32 v23, 0
    s_lshr_b32 s44, s46, 2
    s_add_u32 s44, s44, 397312
    v_add_f32_dpp v21, v21, v21 quad_perm:[1,0,3,2] row_mask:0xf bank_mask:0xf
    s_nop 1
    v_add_f32_dpp v21, v21, v21 quad_perm:[2,3,0,1] row_mask:0xf bank_mask:0xf
    s_nop 1
    v_add_f32_dpp v21, v21, v21 row_half_mirror row_mask:0xf bank_mask:0xf
    s_nop 1
    v_add_f32_dpp v21, v21, v21 row_mirror row_mask:0xf bank_mask:0xf
    v_and_or_b32 v20, v20, v3, s40
    v_and_or_b32 v21, v21, v3, s40
    v_and_or_b32 v22, v22, v3, s40
    v_and_or_b32 v23, v23, v3, s40
    s_cbranch_execz G_24
    s_setprio 3
    s_mov_b64 exec, 0xff
    buffer_store_dwordx4 v[20:23], v14, s[28:31], s44 offen sc1
    s_mov_b64 exec, -1
    s_setprio 0
G_24:
NOML:
    s_nop 4
    v_mov_b32_dpp v24, v26 quad_perm:[0,1,2,3] row_mask:0xc bank_mask:0xf
    v_mov_b32_dpp v25, v27 quad_perm:[0,1,2,3] row_mask:0xc bank_mask:0xf
    ds_write_b64 v4, v[24:25] offset:14976
    v_lshrrev_b32 v5, 4, v0
    s_bitcmp1_b32 s37, 3
    s_cselect_b32 s52, 3, 0
    s_cselect_b32 s44, 8, 0
    s_cmp_ge_u32 s3, s44
    s_waitcnt lgkmcnt(0)
    s_cbranch_scc1 BEND
    s_cmp_ge_u32 s53, 14
    s_cbranch_scc1 FINAL
    s_cmp_lt_u32 s53, 6

    s_cselect_b32 s53, s53, 63
    s_mul_i32 s44, s36, 6
    s_add_u32 s53, s53, s44
    s_cmp_lt_u32 s53, 43
    s_cbranch_scc0 BEND
    s_mov_b32 s52, 2
    s_cmp_eq_u32 s3, 8
    s_cbranch_scc1 GATEW
    v_lshrrev_b32 v16, 2, v0
    s_lshl_b32 s44, s3, 6
    v_add_u32 v16, s44, v16
    v_and_b32 v17, 0x30, v14
    s_lshl_b32 s44, s53, 6
    v_or_b32 v17, s44, v17
    s_movk_i32 s45, 2752
    v_mad_u32_u24 v16, v16, s45, v17
    v_add_u32 v17, 44032, v16
    v_add_u32 v18, 88064, v16
    v_add_u32 v19, 132096, v16
    s_cbranch_execz G_25
    s_barrier
    global_load_dwordx4 v[40:43], v18, s[16:17]
    global_load_dwordx4 v[44:47], v19, s[16:17]
    global_load_dwordx4 v[32:35], v16, s[16:17]
    global_load_dwordx4 v[36:39], v17, s[16:17]
G_25:
    s_lshl_b32 s45, s3, 7
    v_and_b32 v11, 1, v5
    v_and_b32 v9, 2, v5
    v_lshl_or_b32 v11, v9, 2, v11
    v_and_b32 v9, 0x30, v14
    v_and_or_b32 v9, v0, 4, v9
    v_bfe_u32 v10, v0, 3, 1
    v_lshl_or_b32 v9, v10, 1, v9
    v_or_b32 v9, v9, v11
    v_lshl_or_b32 v9, v9, 1, s45
    v_and_b32 v12, 7, v0
    v_lshl_or_b32 v12, v5, 3, v12
    v_lshl_add_u32 v13, v12, 1, s44
    s_cbranch_execz G_26
    global_load_ushort v9, v9, s[4:5]
    global_load_ushort v13, v13, s[18:19]
G_26:
    s_mov_b32 s55, 0x05040100
    s_mov_b32 s56, 0x07060302
    s_mul_i32 s47, s3, 4352
    v_lshlrev_b32 v15, 2, v15
    v_lshl_or_b32 v11, v11, 6, v15
    v_add_u32 v11, s47, v11
    v_lshlrev_b32 v4, 3, v15
    v_and_or_b32 v4, v0, 16, v4
    v_add_u32 v4, 512, v4
    v_cmp_gt_u32 vcc, 32, v0
    s_nop 1
    v_cndmask_b32 v4, v4, v14, vcc
    s_lshl_b32 s44, s3, 8
    s_and_b32 s44, s44, 0x400
    s_lshl_b32 s45, s3, 2
    s_and_b32 s45, s45, 12
    s_or_b32 s44, s44, s45
    v_or_b32 v4, s44, v4
    v_lshlrev_b32 v12, 4, v12
    v_add_u32 v12, 512, v12
    v_lshlrev_b32 v1, 2, v15
    v_add_u32 v1, 128, v1
    v_cmp_eq_u32 vcc, 0, v10
    s_nop 1
    v_cndmask_b32 v12, v1, v12, vcc
    v_add_u32 v10, s47, v14
    v_mul_u32_u24 v5, 1088, v5
    v_add3_u32 v5, v5, s47, v15
    s_mul_i32 s48, s3, 12288
    s_lshl_b32 s44, s53, 7
    s_add_u32 s48, s48, s44
    s_add_u32 s48, s48, 430080
    v_lshrrev_b32 v7, 5, v0
    v_mul_u32_u24 v7, 6016, v7
    v_add_u32 v7, v7, v6
    s_and_b32 s57, s36, 7
    s_lshl3_add_u32 s57, s57, s3
    s_lshl_b32 s57, s57, 12
    s_add_u32 s57, s57, 528384
    v_mov_b32 v1, 0x3b000000
    v_mov_b32 v15, 0xbdd2d3e8
    v_mov_b32 v112, s42
    v_mov_b32 v113, s42
    v_mov_b32 v114, s42
    v_mov_b32 v115, s42
    v_mov_b32 v116, s42
    v_mov_b32 v117, s42
    v_mov_b32 v118, s42
    v_mov_b32 v119, s42
    v_mov_b32 v120, s42
    v_mov_b32 v121, s42
    v_mov_b32 v122, s42
    v_mov_b32 v123, s42
    v_mov_b32 v124, s42
    v_mov_b32 v125, s42
    v_mov_b32 v126, s42
    v_mov_b32 v127, s42
    v_mov_b32 v16, 0x3f803f80
    v_mov_b32 v17, 0x3f803f80
    v_mov_b32 v18, 0x3f803f80
    v_mov_b32 v19, 0x3f803f80
    v_mov_b32 v20, 0x3f803f80
    v_mov_b32 v21, 0x3f803f80
    v_mov_b32 v22, 0x3f803f80
    v_mov_b32 v23, 0x3f803f80
    s_waitcnt vmcnt(5)
    ds_write_b128 v10, v[40:43] offset:27392
    s_waitcnt vmcnt(4)
    ds_write_b128 v10, v[44:47] offset:28416
    s_waitcnt vmcnt(3)
    ds_write_b128 v10, v[32:35] offset:25344
    s_waitcnt vmcnt(2)
    ds_write_b128 v10, v[36:39] offset:26368
    ds_read_b32 v96, v11 offset:25344
    ds_read_b32 v97, v11 offset:26368
    ds_read_b32 v98, v11 offset:27392
    ds_read_b32 v99, v11 offset:28416
    ds_read_b32 v100, v11 offset:25600
    ds_read_b32 v101, v11 offset:26624
    ds_read_b32 v102, v11 offset:27648
    ds_read_b32 v103, v11 offset:28672
    ds_read_b32 v104, v11 offset:25472
    ds_read_b32 v105, v11 offset:26496
    ds_read_b32 v106, v11 offset:27520
    ds_read_b32 v107, v11 offset:28544
    ds_read_b32 v108, v11 offset:25728
    ds_read_b32 v109, v11 offset:26752
    ds_read_b32 v110, v11 offset:27776
    ds_read_b32 v111, v11 offset:28800
    s_waitcnt lgkmcnt(0)
    v_perm_b32 v64, v97, v96, s55
    v_perm_b32 v68, v97, v96, s56
    v_perm_b32 v65, v99, v98, s55
    v_perm_b32 v69, v99, v98, s56
    v_perm_b32 v66, v101, v100, s55
    v_perm_b32 v70, v101, v100, s56
    v_perm_b32 v67, v103, v102, s55
    v_perm_b32 v71, v103, v102, s56
    v_perm_b32 v72, v105, v104, s55
    v_perm_b32 v76, v105, v104, s56
    v_perm_b32 v73, v107, v106, s55
    v_perm_b32 v77, v107, v106, s56
    v_perm_b32 v74, v109, v108, s55
    v_perm_b32 v78, v109, v108, s56
    v_perm_b32 v75, v111, v110, s55
    v_perm_b32 v79, v111, v110, s56
    v_mfma_f32_16x16x32_bf16 v[24:27], v[16:19], v[64:67], 0
    v_mfma_f32_16x16x32_bf16 v[28:31], v[16:19], v[68:71], 0
    v_mfma_f32_16x16x32_bf16 v[24:27], v[16:19], v[72:75], v[24:27]
    v_mfma_f32_16x16x32_bf16 v[28:31], v[16:19], v[76:79], v[28:31]
    s_nop 7
    v_mov_b32_dpp v24, v28 quad_perm:[0,1,2,3] row_mask:0x8 bank_mask:0xf
    ds_write_b32 v4, v24 offset:23296
    s_waitcnt vmcnt(0) lgkmcnt(0)
    s_cbranch_execz G_27
    s_barrier
    buffer_load_dwordx4 v[112:115], v14, s[28:31], s57 offen offset:0 sc1
    buffer_load_dwordx4 v[116:119], v14, s[28:31], s57 offen offset:1024 sc1
    buffer_load_dwordx4 v[120:123], v14, s[28:31], s57 offen offset:2048 sc1
    buffer_load_dwordx4 v[124:127], v14, s[28:31], s57 offen offset:3072 sc1
G_27:
    ds_read_b128 v[40:43], v12 offset:23296
    ds_read_b128 v[44:47], v12 offset:24320
    ds_read_b32 v96, v5 offset:60160
    ds_read_b32 v97, v5 offset:60288
    ds_read_b32 v98, v5 offset:60416
    ds_read_b32 v99, v5 offset:60544
    ds_read_b32 v100, v5 offset:60672
    ds_read_b32 v101, v5 offset:60800
    ds_read_b32 v102, v5 offset:60928
    ds_read_b32 v103, v5 offset:61056
    ds_read_b32 v104, v5 offset:60224
    ds_read_b32 v105, v5 offset:60352
    ds_read_b32 v106, v5 offset:60480
    ds_read_b32 v107, v5 offset:60608
    ds_read_b32 v108, v5 offset:60736
    ds_read_b32 v109, v5 offset:60864
    ds_read_b32 v110, v5 offset:60992
    ds_read_b32 v111, v5 offset:61120
    s_waitcnt lgkmcnt(0)
    v_perm_b32 v80, v97, v96, s55
    v_perm_b32 v84, v97, v96, s56
    v_perm_b32 v81, v99, v98, s55
    v_perm_b32 v85, v99, v98, s56
    v_perm_b32 v82, v101, v100, s55
    v_perm_b32 v86, v101, v100, s56
    v_perm_b32 v83, v103, v102, s55
    v_perm_b32 v87, v103, v102, s56
    v_perm_b32 v88, v105, v104, s55
    v_perm_b32 v92, v105, v104, s56
    v_perm_b32 v89, v107, v106, s55
    v_perm_b32 v93, v107, v106, s56
    v_perm_b32 v90, v109, v108, s55
    v_perm_b32 v94, v109, v108, s56
    v_perm_b32 v91, v111, v110, s55
    v_perm_b32 v95, v111, v110, s56
    v_pk_add_f32 v[40:41], v[40:41], v[44:45]
    v_pk_add_f32 v[42:43], v[42:43], v[46:47]
    v_pk_add_f32 v[40:41], v[40:41], v[42:43]
    v_add_f32 v40, v40, v41
    v_lshlrev_b32 v9, 16, v9
    v_lshlrev_b32 v13, 16, v13
    s_mov_b32 s50, 262144
    s_cbranch_execnz CK_29
RT_28:
    v_or_b32 v104, v96, v97
    v_cmp_ne_u32_sdwa vcc, v104, 0 src0_sel:BYTE_0 src1_sel:DWORD
    s_cbranch_vccz SK_31
    s_mov_b64 exec, vcc
    buffer_load_dwordx4 v[112:115], v14, s[28:31], s57 offen offset:0 sc1
    s_mov_b64 exec, s[34:35]
SK_31:
    v_or_b32 v104, v98, v99
    v_cmp_ne_u32_sdwa vcc, v104, 0 src0_sel:BYTE_0 src1_sel:DWORD
    s_cbranch_vccz SK_32
    s_mov_b64 exec, vcc
    buffer_load_dwordx4 v[116:119], v14, s[28:31], s57 offen offset:1024 sc1
    s_mov_b64 exec, s[34:35]
SK_32:
    v_or_b32 v104, v100, v101
    v_cmp_ne_u32_sdwa vcc, v104, 0 src0_sel:BYTE_0 src1_sel:DWORD
    s_cbranch_vccz SK_33
    s_mov_b64 exec, vcc
    buffer_load_dwordx4 v[120:123], v14, s[28:31], s57 offen offset:2048 sc1
    s_mov_b64 exec, s[34:35]
SK_33:
    v_or_b32 v104, v102, v103
    v_cmp_ne_u32_sdwa vcc, v104, 0 src0_sel:BYTE_0 src1_sel:DWORD
    s_cbranch_vccz SK_34
    s_mov_b64 exec, vcc
    buffer_load_dwordx4 v[124:127], v14, s[28:31], s57 offen offset:3072 sc1
    s_mov_b64 exec, s[34:35]
SK_34:
    s_waitcnt vmcnt(3)
    s_sub_u32 s50, s50, 1
    s_cbranch_scc1 OK_30
CK_29:
    v_bitop3_b32 v96, v112, v113, s40 bitop3:0x7e
    v_bitop3_b32 v97, v114, v115, s40 bitop3:0x7e
    v_bitop3_b32 v98, v116, v117, s40 bitop3:0x7e
    v_bitop3_b32 v99, v118, v119, s40 bitop3:0x7e
    v_bitop3_b32 v100, v120, v121, s40 bitop3:0x7e
    v_bitop3_b32 v101, v122, v123, s40 bitop3:0x7e
    v_bitop3_b32 v102, v124, v125, s40 bitop3:0x7e
    v_bitop3_b32 v103, v126, v127, s40 bitop3:0x7e
    v_or3_b32 v104, v96, v97, v98
    v_or3_b32 v104, v104, v99, v100
    v_or3_b32 v104, v104, v101, v102
    v_or_b32 v104, v104, v103
    v_cmp_ne_u32_sdwa vcc, v104, 0 src0_sel:BYTE_0 src1_sel:DWORD
    s_cbranch_vccnz RT_28
OK_30:
    v_pk_add_f32 v[96:97], v[112:113], v[116:117]
    v_pk_add_f32 v[98:99], v[114:115], v[118:119]
    v_pk_add_f32 v[100:101], v[120:121], v[124:125]
    v_pk_add_f32 v[102:103], v[122:123], v[126:127]
    v_pk_add_f32 v[96:97], v[96:97], v[100:101]
    v_pk_add_f32 v[98:99], v[98:99], v[102:103]
    s_nop 1
    v_permlane32_swap_b32 v96, v98
    v_permlane32_swap_b32 v97, v99
    v_pk_add_f32 v[96:97], v[96:97], v[98:99]
    s_nop 1
    v_permlane16_swap_b32 v96, v97
    v_add_f32 v96, v96, v97
    v_cvt_pk_bf16_f32 v96, 0, v96
    v_add_f32 v96, v96, v9
    s_nop 1
    v_mov_b32_dpp v97, v96 quad_perm:[1,0,3,2] row_mask:0xf bank_mask:0xf
    v_cvt_pk_bf16_f32 v97, v96, v97
    s_nop 1
    v_mov_b32_dpp v16, v97 row_newbcast:0 row_mask:0xf bank_mask:0xe
    v_mov_b32_dpp v17, v97 row_newbcast:2 row_mask:0xf bank_mask:0xe
    v_mov_b32_dpp v18, v97 row_newbcast:4 row_mask:0xf bank_mask:0xe
    v_mov_b32_dpp v19, v97 row_newbcast:6 row_mask:0xf bank_mask:0xe
    v_mov_b32_dpp v20, v97 row_newbcast:8 row_mask:0xf bank_mask:0xe
    v_mov_b32_dpp v21, v97 row_newbcast:10 row_mask:0xf bank_mask:0xe
    v_mov_b32_dpp v22, v97 row_newbcast:12 row_mask:0xf bank_mask:0xe
    v_mov_b32_dpp v23, v97 row_newbcast:14 row_mask:0xf bank_mask:0xe
    v_mfma_f32_16x16x32_bf16 v[104:107], v[16:19], v[16:19], 0
    v_mfma_f32_16x16x32_bf16 v[24:27], v[16:19], v[64:67], 0
    v_mfma_f32_16x16x32_bf16 v[28:31], v[16:19], v[68:71], 0
    v_mfma_f32_16x16x32_bf16 v[104:107], v[20:23], v[20:23], v[104:107]
    v_mfma_f32_16x16x32_bf16 v[24:27], v[20:23], v[72:75], v[24:27]
    v_mfma_f32_16x16x32_bf16 v[28:31], v[20:23], v[76:79], v[28:31]
    s_nop 6
    v_mov_b32_dpp v24, v104 quad_perm:[0,1,2,3] row_mask:0x2 bank_mask:0xf
    s_nop 1
    v_mov_b32_dpp v24, v28 quad_perm:[0,1,2,3] row_mask:0x8 bank_mask:0xf
    ds_write_b32 v4, v24 offset:21248
    s_waitcnt lgkmcnt(0)
    s_cbranch_execz G_35
    s_barrier
G_35:
    ds_read_b128 v[96:99], v12 offset:21248
    ds_read_b128 v[100:103], v12 offset:22272
    s_waitcnt lgkmcnt(0)
    v_pk_add_f32 v[96:97], v[96:97], v[100:101]
    v_pk_add_f32 v[98:99], v[98:99], v[102:103]
    v_pk_add_f32 v[96:97], v[96:97], v[98:99]
    v_add_f32 v96, v96, v97
    s_nop 1
    v_mul_f32_dpp v97, v96, v1 row_newbcast:8 row_mask:0xf bank_mask:0xf
    v_mul_f32_dpp v98, v96, v1 row_newbcast:12 row_mask:0xf bank_mask:0xf
    v_fma_f32 v98, -v97, v97, v98
    v_max_f32 v98, 0, v98
    v_cvt_pk_bf16_f32 v99, 0, v98
    v_add_f32 v99, 0x3727c5ac, v99
    v_cvt_pk_bf16_f32 v99, 0, v99
    v_sqrt_f32 v99, v99
    v_fma_f32 v96, -v97, v40, v96
    v_cvt_pk_bf16_f32 v99, 0, v99
    v_rcp_f32 v99, v99
    s_nop 0
    v_mul_f32 v98, v98, v99
    v_mul_f32 v98, v98, v99
    v_cvt_pk_bf16_f32 v98, 0, v98
    v_add_f32 v98, 0x3727c5ac, v98
    v_cvt_pk_bf16_f32 v98, 0, v98
    v_sqrt_f32 v98, v98
    v_mul_f32 v96, v96, v99
    v_cvt_pk_bf16_f32 v98, 0, v98
    v_rcp_f32 v98, v98
    s_nop 0
    v_mul_f32 v96, v96, v98
    v_cvt_pk_bf16_f32 v96, 0, v96
    v_add_f32 v96, v96, v13
    v_cvt_pk_bf16_f32 v96, 0, v96
    v_mul_f32 v99, v96, v96
    v_fmaak_f32 v99, v99, v15, 0xc0135761
    v_mul_f32 v99, v99, v96
    v_exp_f32 v99, v99
    s_nop 0
    v_add_f32 v99, 1.0, v99
    v_rcp_f32 v99, v99
    s_nop 0
    v_mul_f32 v96, v99, v96
    s_nop 1
    v_mov_b32_dpp v99, v96 quad_perm:[1,0,3,2] row_mask:0xf bank_mask:0xf
    v_cvt_pk_bf16_f32 v99, v96, v99
    s_nop 1
    v_mov_b32_dpp v16, v99 row_newbcast:0 row_mask:0xf bank_mask:0xf
    v_mov_b32_dpp v17, v99 row_newbcast:2 row_mask:0xf bank_mask:0xf
    v_mov_b32_dpp v18, v99 row_newbcast:4 row_mask:0xf bank_mask:0xf
    v_mov_b32_dpp v19, v99 row_newbcast:6 row_mask:0xf bank_mask:0xf
    s_nop 1
    v_mfma_f32_16x16x32_bf16 v[24:27], v[16:19], v[80:83], 0
    v_mfma_f32_16x16x32_bf16 v[28:31], v[16:19], v[84:87], 0
    v_mfma_f32_16x16x32_bf16 v[104:107], v[16:19], v[88:91], 0
    v_mfma_f32_16x16x32_bf16 v[108:111], v[16:19], v[92:95], 0
    s_nop 5
    v_mov_b32_dpp v24, v28 quad_perm:[0,1,2,3] row_mask:0x2 bank_mask:0xf
    s_nop 1
    v_mov_b32_dpp v24, v104 quad_perm:[0,1,2,3] row_mask:0x4 bank_mask:0xf
    s_nop 1
    v_mov_b32_dpp v24, v108 quad_perm:[0,1,2,3] row_mask:0x8 bank_mask:0xf
    v_and_or_b32 v24, v24, v3, s40
    s_cbranch_execz G_36
    buffer_store_dword v24, v7, s[28:31], s48 offen sc1
G_36:
    s_branch END
FINAL:
    s_mov_b32 s52, 1
    s_cmp_lg_u32 s3, 2
    s_cbranch_scc1 BEND
    s_and_b32 s45, s37, 1
    s_lshl1_add_u32 s53, s36, s45
    v_bfe_u32 v16, v0, 2, 1
    v_lshl_or_b32 v10, v5, 1, v16
    v_and_b32 v17, 3, v0
    v_lshl_or_b32 v10, v17, 3, v10
    s_lshl_b32 s44, s53, 6
    v_lshl_or_b32 v9, v10, 1, s44
    v_lshlrev_b32 v10, 2, v10
    v_and_b32 v11, 1, v5
    v_lshl_or_b32 v11, v16, 1, v11
    v_and_b32 v17, 2, v0
    v_lshl_or_b32 v11, v17, 1, v11
    v_and_b32 v17, 2, v5
    v_lshl_or_b32 v11, v17, 2, v11
    v_and_or_b32 v11, v14, 16, v11
    v_lshlrev_b32 v11, 2, v11
    v_and_b32 v1, 62, v0
    v_lshlrev_b32 v1, 5, v1
    v_and_or_b32 v1, v14, 16, v1
    s_lshl_b32 s57, s36, 12
    s_lshl_b32 s45, s45, 5
    s_add_u32 s57, s57, s45
    s_add_u32 s57, s57, 757760
    s_mul_i32 s58, s53, 6144
    s_add_u32 s58, s58, 430080
    s_add_u32 s59, s58, 4096
    v_mov_b32 v15, s40
    v_mov_b32 v16, s42
    v_mov_b32 v17, s42
    v_cmp_gt_u32 vcc, 24, v0
    s_add_u32 s44, s41, 1
    v_mov_b32 v12, s44
    v_mov_b32 v13, 393216
    v_mov_b64 v[64:65], v[16:17]
    v_mov_b64 v[66:67], v[16:17]
    v_mov_b64 v[68:69], v[16:17]
    v_mov_b64 v[70:71], v[16:17]
    v_mov_b64 v[72:73], v[16:17]
    v_mov_b64 v[74:75], v[16:17]
    v_mov_b64 v[76:77], v[16:17]
    v_mov_b64 v[78:79], v[16:17]
    v_mov_b64 v[80:81], v[16:17]
    v_mov_b64 v[82:83], v[16:17]
    v_mov_b64 v[84:85], v[16:17]
    v_mov_b64 v[86:87], v[16:17]
    v_mov_b64 v[88:89], v[16:17]
    v_mov_b64 v[90:91], v[16:17]
    v_cndmask_b32 v92, v15, v17, vcc
    v_cndmask_b32 v93, v15, v17, vcc
    v_cndmask_b32 v94, v15, v17, vcc
    v_cndmask_b32 v95, v15, v17, vcc
    s_cbranch_execz G_37
    s_barrier
    s_barrier
G_37:
    s_cbranch_execz G_38
    global_load_ushort v18, v9, s[4:5]
    global_load_ushort v19, v9, s[22:23]
    s_waitcnt vmcnt(0)
G_38:
    v_lshlrev_b32 v18, 16, v18
    v_lshlrev_b32 v19, 16, v19
    s_mov_b32 s50, 262144
    s_cbranch_execnz CK_40
RT_39:
    v_or_b32 v100, v96, v97
    v_cmp_ne_u32_sdwa vcc, v100, 0 src0_sel:BYTE_0 src1_sel:DWORD
    s_cbranch_vccz SK_42
    s_mov_b64 exec, vcc
    buffer_load_dwordx4 v[64:67], v1, s[28:31], s57 offen offset:0 sc1
    s_mov_b64 exec, s[34:35]
SK_42:
    v_or_b32 v100, v98, v99
    v_cmp_ne_u32_sdwa vcc, v100, 0 src0_sel:BYTE_0 src1_sel:DWORD
    s_cbranch_vccz SK_43
    s_mov_b64 exec, vcc
    buffer_load_dwordx4 v[68:71], v1, s[28:31], s57 offen offset:2048 sc1
    s_mov_b64 exec, s[34:35]
SK_43:
    s_waitcnt vmcnt(1)
    s_sub_u32 s50, s50, 1
    s_cbranch_scc1 OK_41
CK_40:
    v_bitop3_b32 v96, v64, v65, s40 bitop3:0x7e
    v_bitop3_b32 v97, v66, v67, s40 bitop3:0x7e
    v_bitop3_b32 v98, v68, v69, s40 bitop3:0x7e
    v_bitop3_b32 v99, v70, v71, s40 bitop3:0x7e
    v_or3_b32 v100, v96, v97, v98
    v_or_b32 v100, v100, v99
    v_cmp_ne_u32_sdwa vcc, v100, 0 src0_sel:BYTE_0 src1_sel:DWORD
    s_cbranch_vccnz RT_39
OK_41:
    v_pk_add_f32 v[96:97], v[64:65], v[68:69]
    v_pk_add_f32 v[98:99], v[66:67], v[70:71]
    s_nop 1
    v_permlane32_swap_b32 v96, v98
    v_permlane32_swap_b32 v97, v99
    v_pk_add_f32 v[96:97], v[96:97], v[98:99]
    s_nop 1
    v_permlane16_swap_b32 v96, v97
    v_add_f32 v96, v96, v97
    s_nop 1
    v_add_f32_dpp v96, v96, v96 row_ror:8 row_mask:0xf bank_mask:0xf
    v_cvt_pk_bf16_f32 v96, 0, v96
    ds_write_b32 v11, v96 offset:21248
    ds_read_b32 v96, v10 offset:21248
    s_waitcnt lgkmcnt(0)
    v_add_f32 v18, v18, v96
    v_cvt_pk_bf16_f32 v18, 0, v18
    s_add_u32 s58, s58, 2048
    v_add_u32 v2, s58, v14
    v_mov_b64 v[48:49], 0
    s_mov_b32 s50, 262144
    s_cbranch_execnz CK_45
RT_44:
    v_or_b32 v108, v96, v97
    v_cmp_ne_u32_sdwa vcc, v108, 0 src0_sel:BYTE_0 src1_sel:DWORD
    s_cbranch_vccz SK_47
    s_mov_b64 exec, vcc
    global_atomic_or_x2 v[72:73], v2, v[48:49], s[28:29] offset:-2048 sc0 sc1
    global_atomic_or_x2 v[74:75], v2, v[48:49], s[28:29] offset:-2040 sc0 sc1
    s_mov_b64 exec, s[34:35]
SK_47:
    v_or_b32 v108, v98, v99
    v_cmp_ne_u32_sdwa vcc, v108, 0 src0_sel:BYTE_0 src1_sel:DWORD
    s_cbranch_vccz SK_48
    s_mov_b64 exec, vcc
    global_atomic_or_x2 v[76:77], v2, v[48:49], s[28:29] offset:-1024 sc0 sc1
    global_atomic_or_x2 v[78:79], v2, v[48:49], s[28:29] offset:-1016 sc0 sc1
    s_mov_b64 exec, s[34:35]
SK_48:
    v_or_b32 v108, v100, v101
    v_cmp_ne_u32_sdwa vcc, v108, 0 src0_sel:BYTE_0 src1_sel:DWORD
    s_cbranch_vccz SK_49
    s_mov_b64 exec, vcc
    global_atomic_or_x2 v[80:81], v2, v[48:49], s[28:29] offset:0 sc0 sc1
    global_atomic_or_x2 v[82:83], v2, v[48:49], s[28:29] offset:8 sc0 sc1
    s_mov_b64 exec, s[34:35]
SK_49:
    v_or_b32 v108, v102, v103
    v_cmp_ne_u32_sdwa vcc, v108, 0 src0_sel:BYTE_0 src1_sel:DWORD
    s_cbranch_vccz SK_50
    s_mov_b64 exec, vcc
    global_atomic_or_x2 v[84:85], v2, v[48:49], s[28:29] offset:1024 sc0 sc1
    global_atomic_or_x2 v[86:87], v2, v[48:49], s[28:29] offset:1032 sc0 sc1
    s_mov_b64 exec, s[34:35]
SK_50:
    v_or_b32 v108, v104, v105
    v_cmp_ne_u32_sdwa vcc, v108, 0 src0_sel:BYTE_0 src1_sel:DWORD
    s_cbranch_vccz SK_51
    s_mov_b64 exec, vcc
    global_atomic_or_x2 v[88:89], v2, v[48:49], s[28:29] offset:2048 sc0 sc1
    global_atomic_or_x2 v[90:91], v2, v[48:49], s[28:29] offset:2056 sc0 sc1
    s_mov_b64 exec, s[34:35]
SK_51:
    v_or_b32 v108, v106, v107
    v_cmp_ne_u32_sdwa vcc, v108, 0 src0_sel:BYTE_0 src1_sel:DWORD
    s_cbranch_vccz SK_52
    s_mov_b64 exec, vcc
    global_atomic_or_x2 v[92:93], v2, v[48:49], s[28:29] offset:3072 sc0 sc1
    global_atomic_or_x2 v[94:95], v2, v[48:49], s[28:29] offset:3080 sc0 sc1
    s_mov_b64 exec, s[34:35]
SK_52:
    s_waitcnt vmcnt(36)
    s_sub_u32 s50, s50, 1
    s_cbranch_scc1 OK_46
CK_45:
    v_bitop3_b32 v96, v72, v73, s40 bitop3:0x7e
    v_bitop3_b32 v97, v74, v75, s40 bitop3:0x7e
    v_bitop3_b32 v98, v76, v77, s40 bitop3:0x7e
    v_bitop3_b32 v99, v78, v79, s40 bitop3:0x7e
    v_bitop3_b32 v100, v80, v81, s40 bitop3:0x7e
    v_bitop3_b32 v101, v82, v83, s40 bitop3:0x7e
    v_bitop3_b32 v102, v84, v85, s40 bitop3:0x7e
    v_bitop3_b32 v103, v86, v87, s40 bitop3:0x7e
    v_bitop3_b32 v104, v88, v89, s40 bitop3:0x7e
    v_bitop3_b32 v105, v90, v91, s40 bitop3:0x7e
    v_bitop3_b32 v106, v92, v93, s40 bitop3:0x7e
    v_bitop3_b32 v107, v94, v95, s40 bitop3:0x7e
    v_or3_b32 v108, v96, v97, v98
    v_or3_b32 v108, v108, v99, v100
    v_or3_b32 v108, v108, v101, v102
    v_or3_b32 v108, v108, v103, v104
    v_or3_b32 v108, v108, v105, v106
    v_or_b32 v108, v108, v107
    v_cmp_ne_u32_sdwa vcc, v108, 0 src0_sel:BYTE_0 src1_sel:DWORD
    s_cbranch_vccnz RT_44
OK_46:
    v_pk_add_f32 v[96:97], v[72:73], v[76:77]
    v_pk_add_f32 v[98:99], v[74:75], v[78:79]
    v_pk_add_f32 v[100:101], v[80:81], v[84:85]
    v_pk_add_f32 v[102:103], v[82:83], v[86:87]
    v_pk_add_f32 v[104:105], v[88:89], v[92:93]
    v_pk_add_f32 v[106:107], v[90:91], v[94:95]
    v_pk_add_f32 v[96:97], v[96:97], v[100:101]
    v_pk_add_f32 v[98:99], v[98:99], v[102:103]
    v_pk_add_f32 v[96:97], v[96:97], v[104:105]
    v_pk_add_f32 v[98:99], v[98:99], v[106:107]
    s_nop 1
    v_permlane32_swap_b32 v96, v98
    v_permlane32_swap_b32 v97, v99
    v_pk_add_f32 v[96:97], v[96:97], v[98:99]
    s_nop 1
    v_permlane16_swap_b32 v96, v97
    v_add_f32 v96, v96, v97
    s_nop 1
    v_add_f32_dpp v96, v96, v96 row_ror:8 row_mask:0xf bank_mask:0xf
    v_cvt_pk_bf16_f32 v96, 0, v96
    v_add_f32 v96, v96, v19
    v_cvt_pk_bf16_f32 v96, 0, v96
    v_add_f32 v96, v96, v18
    v_cvt_pk_bf16_f32 v96, v96, v96
    s_cmp_lg_u32 s53, 0
    s_cbranch_execz G_53
    global_store_short v9, v96, s[24:25]
    s_cbranch_scc1 NOEP
    s_mov_b64 exec, 1
    buffer_store_dword v12, v13, s[28:31], 0 offen
NOEP:
G_53:
END:
    s_cmp_eq_u32 s34, 0
    s_cbranch_scc1 DRYRET
ENDX:
END0:
    s_endpgm
GATEW:
    s_barrier
BEND:
    s_cbranch_execz G_54
    s_barrier
G_54:
    s_branch END
DRY:
    s_mov_b64 exec, 0
    s_mov_b32 s32, 64
    s_cmp_eq_u32 s3, 13
    s_cbranch_scc1 QW2
    s_cmp_eq_u32 s3, 14
    s_cselect_b32 s3, 2, s3
    s_branch MAIN
DRYRET:
    s_max_u32 s3, s3, 14
    s_setprio 3
    s_branch QWX
QW2:
    s_load_dword s41, s[28:29], 393216
    v_and_b32 v16, 1, v0
    v_lshlrev_b32 v16, 4, v16
    s_mov_b32 s44, 0xffff
    v_lshlrev_b32 v16, v16, s44
    v_bfe_u32 v17, v0, 1, 2
    v_cmp_eq_u32 vcc, 0, v17
    s_nop 1
    v_cndmask_b32 v9, 0, v16, vcc
    v_cmp_eq_u32 vcc, 1, v17
    s_nop 1
    v_cndmask_b32 v10, 0, v16, vcc
    v_cmp_eq_u32 vcc, 2, v17
    s_nop 1
    v_cndmask_b32 v11, 0, v16, vcc
    v_cmp_eq_u32 vcc, 3, v17
    s_nop 1
    v_cndmask_b32 v12, 0, v16, vcc
    v_and_b32 v15, 0x30, v0
    v_and_b32 v16, 7, v0
    v_lshlrev_b32 v16, 3, v16
    v_lshl_or_b32 v15, v15, 2, v16
    v_and_b32 v16, 8, v0
    v_lshl_or_b32 v15, v16, 27, v15
    s_mov_b32 s45, 0x3f803f80
    v_mov_b64 v[20:21], 0
    v_mov_b32 v3, 0xffffff00
    v_lshlrev_b32 v7, 3, v0
    s_mov_b32 s30, 790528
    s_mov_b32 s31, 0x00020000
    s_lshl_b32 s46, s38, 9
    s_add_u32 s51, s46, 131072
    s_lshl_b32 s44, s3, 8
    s_or_b32 s46, s46, s44
    s_waitcnt vmcnt(8)
    v_dot2c_f32_bf16 v20, s45, v24
    v_dot2c_f32_bf16 v20, s45, v25
    v_dot2c_f32_bf16 v20, s45, v26
    v_dot2c_f32_bf16 v20, s45, v27
    s_nop 2
    v_add_f32_dpp v20, v20, v20 quad_perm:[1,0,3,2] row_mask:0xf bank_mask:0xf
    s_nop 1
    v_add_f32_dpp v20, v20, v20 quad_perm:[2,3,0,1] row_mask:0xf bank_mask:0xf
    s_nop 1
    v_add_f32_dpp v20, v20, v20 row_half_mirror row_mask:0xf bank_mask:0xf
    s_nop 1
    v_add_f32_dpp v20, v20, v20 row_mirror row_mask:0xf bank_mask:0xf
    s_nop 1
    v_add_f32_dpp v20, v20, v20 row_bcast:15 row_mask:0xa bank_mask:0xf
    s_nop 1
    v_add_f32_dpp v20, v20, v20 row_bcast:31 row_mask:0xc bank_mask:0xf
    s_nop 0
    v_readlane_b32 s44, v20, 63
    v_mov_b32 v22, 0x3b000000
    s_nop 0
    v_mul_f32 v20, s44, v22
    v_lshlrev_b32 v23, 16, v24
    v_and_b32 v28, 0xffff0000, v24
    v_sub_f32 v23, v23, v20
    v_sub_f32 v28, v28, v20
    v_fmac_f32 v21, v23, v23
    v_fmac_f32 v21, v28, v28
    v_lshlrev_b32 v23, 16, v25
    v_and_b32 v28, 0xffff0000, v25
    v_sub_f32 v23, v23, v20
    v_sub_f32 v28, v28, v20
    v_fmac_f32 v21, v23, v23
    v_fmac_f32 v21, v28, v28
    v_lshlrev_b32 v23, 16, v26
    v_and_b32 v28, 0xffff0000, v26
    v_sub_f32 v23, v23, v20
    v_sub_f32 v28, v28, v20
    v_fmac_f32 v21, v23, v23
    v_fmac_f32 v21, v28, v28
    v_lshlrev_b32 v23, 16, v27
    v_and_b32 v28, 0xffff0000, v27
    v_sub_f32 v23, v23, v20
    v_sub_f32 v28, v28, v20
    v_fmac_f32 v21, v23, v23
    v_fmac_f32 v21, v28, v28
    s_nop 1
    v_add_f32_dpp v21, v21, v21 quad_perm:[1,0,3,2] row_mask:0xf bank_mask:0xf
    s_nop 1
    v_add_f32_dpp v21, v21, v21 quad_perm:[2,3,0,1] row_mask:0xf bank_mask:0xf
    s_nop 1
    v_add_f32_dpp v21, v21, v21 row_half_mirror row_mask:0xf bank_mask:0xf
    s_nop 1
    v_add_f32_dpp v21, v21, v21 row_mirror row_mask:0xf bank_mask:0xf
    s_nop 1
    v_add_f32_dpp v21, v21, v21 row_bcast:15 row_mask:0xa bank_mask:0xf
    s_nop 1
    v_add_f32_dpp v21, v21, v21 row_bcast:31 row_mask:0xc bank_mask:0xf
    s_nop 0
    v_readlane_b32 s44, v21, 63
    v_lshlrev_b32 v18, 16, v8
    v_and_b32 v19, 0xffff0000, v8
    v_mul_f32 v21, s44, v22
    v_cvt_pk_bf16_f32 v20, 0, v20
    v_cvt_pk_bf16_f32 v21, 0, v21
    v_add_f32 v21, 0x3727c5ac, v21
    v_cvt_pk_bf16_f32 v21, 0, v21
    v_sqrt_f32 v21, v21
    v_sub_f32 v18, v18, v20
    v_sub_f32 v19, v19, v20
    v_cvt_pk_bf16_f32 v21, 0, v21
    v_cvt_pk_bf16_f32 v18, 0, v18
    v_cvt_pk_bf16_f32 v19, 0, v19
    v_rcp_f32 v21, v21
    s_nop 0
    v_mul_f32 v18, v18, v21
    v_mul_f32 v19, v19, v21
    v_cvt_pk_bf16_f32 v18, v18, v18
    v_cvt_pk_bf16_f32 v19, v19, v19
    s_cbranch_execz G_55
    s_waitcnt lgkmcnt(0)
G_55:
    s_add_u32 s40, s41, 1
    s_and_b32 s40, s40, 0xff
    s_xor_b32 s42, s40, 1
    v_and_b32_dpp v96, v18, v9 quad_perm:[0,0,0,0] row_mask:0xf bank_mask:0xf
    v_and_b32_dpp v97, v18, v10 quad_perm:[0,0,0,0] row_mask:0xf bank_mask:0xf
    v_and_b32_dpp v98, v18, v11 quad_perm:[0,0,0,0] row_mask:0xf bank_mask:0xf
    v_and_b32_dpp v99, v18, v12 quad_perm:[0,0,0,0] row_mask:0xf bank_mask:0xf
    v_and_b32_dpp v100, v19, v9 quad_perm:[0,0,0,0] row_mask:0xf bank_mask:0xf
    v_and_b32_dpp v101, v19, v10 quad_perm:[0,0,0,0] row_mask:0xf bank_mask:0xf
    v_and_b32_dpp v102, v19, v11 quad_perm:[0,0,0,0] row_mask:0xf bank_mask:0xf
    v_and_b32_dpp v103, v19, v12 quad_perm:[0,0,0,0] row_mask:0xf bank_mask:0xf
    v_and_b32_dpp v104, v18, v9 quad_perm:[1,1,1,1] row_mask:0xf bank_mask:0xf
    v_and_b32_dpp v105, v18, v10 quad_perm:[1,1,1,1] row_mask:0xf bank_mask:0xf
    v_and_b32_dpp v106, v18, v11 quad_perm:[1,1,1,1] row_mask:0xf bank_mask:0xf
    v_and_b32_dpp v107, v18, v12 quad_perm:[1,1,1,1] row_mask:0xf bank_mask:0xf
    v_and_b32_dpp v108, v19, v9 quad_perm:[1,1,1,1] row_mask:0xf bank_mask:0xf
    v_and_b32_dpp v109, v19, v10 quad_perm:[1,1,1,1] row_mask:0xf bank_mask:0xf
    v_and_b32_dpp v110, v19, v11 quad_perm:[1,1,1,1] row_mask:0xf bank_mask:0xf
    v_and_b32_dpp v111, v19, v12 quad_perm:[1,1,1,1] row_mask:0xf bank_mask:0xf
    v_and_b32_dpp v112, v18, v9 quad_perm:[2,2,2,2] row_mask:0xf bank_mask:0xf
    v_and_b32_dpp v113, v18, v10 quad_perm:[2,2,2,2] row_mask:0xf bank_mask:0xf
    v_and_b32_dpp v114, v18, v11 quad_perm:[2,2,2,2] row_mask:0xf bank_mask:0xf
    v_and_b32_dpp v115, v18, v12 quad_perm:[2,2,2,2] row_mask:0xf bank_mask:0xf
    v_and_b32_dpp v116, v19, v9 quad_perm:[2,2,2,2] row_mask:0xf bank_mask:0xf
    v_and_b32_dpp v117, v19, v10 quad_perm:[2,2,2,2] row_mask:0xf bank_mask:0xf
    v_and_b32_dpp v118, v19, v11 quad_perm:[2,2,2,2] row_mask:0xf bank_mask:0xf
    v_and_b32_dpp v119, v19, v12 quad_perm:[2,2,2,2] row_mask:0xf bank_mask:0xf
    v_and_b32_dpp v120, v18, v9 quad_perm:[3,3,3,3] row_mask:0xf bank_mask:0xf
    v_and_b32_dpp v121, v18, v10 quad_perm:[3,3,3,3] row_mask:0xf bank_mask:0xf
    v_and_b32_dpp v122, v18, v11 quad_perm:[3,3,3,3] row_mask:0xf bank_mask:0xf
    v_and_b32_dpp v123, v18, v12 quad_perm:[3,3,3,3] row_mask:0xf bank_mask:0xf
    v_and_b32_dpp v124, v19, v9 quad_perm:[3,3,3,3] row_mask:0xf bank_mask:0xf
    v_and_b32_dpp v125, v19, v10 quad_perm:[3,3,3,3] row_mask:0xf bank_mask:0xf
    v_and_b32_dpp v126, v19, v11 quad_perm:[3,3,3,3] row_mask:0xf bank_mask:0xf
    v_and_b32_dpp v127, v19, v12 quad_perm:[3,3,3,3] row_mask:0xf bank_mask:0xf
    v_mov_b32 v20, s42
    v_mov_b32 v21, s42
    s_waitcnt vmcnt(7)
    v_mfma_f32_16x16x32_bf16 v[24:27], v[96:99], v[64:67], 0
    s_waitcnt vmcnt(6)
    v_mfma_f32_16x16x32_bf16 v[24:27], v[100:103], v[68:71], v[24:27]
    s_waitcnt vmcnt(5)
    v_mfma_f32_16x16x32_bf16 v[24:27], v[104:107], v[72:75], v[24:27]
    s_waitcnt vmcnt(4)
    v_mfma_f32_16x16x32_bf16 v[24:27], v[108:111], v[76:79], v[24:27]
    s_waitcnt vmcnt(3)
    v_mfma_f32_16x16x32_bf16 v[24:27], v[112:115], v[80:83], v[24:27]
    s_waitcnt vmcnt(2)
    v_mfma_f32_16x16x32_bf16 v[24:27], v[116:119], v[84:87], v[24:27]
    s_waitcnt vmcnt(1)
    v_mfma_f32_16x16x32_bf16 v[24:27], v[120:123], v[88:91], v[24:27]
    s_waitcnt vmcnt(0)
    v_mfma_f32_16x16x32_bf16 v[24:27], v[124:127], v[92:95], v[24:27]
    s_nop 7
    v_permlane32_swap_b32 v24, v26
    v_permlane32_swap_b32 v25, v27
    s_nop 0
    v_add_f32_dpp v24, v26, v24 row_ror:8 row_mask:0xf bank_mask:0xf
    v_add_f32_dpp v25, v27, v25 row_ror:8 row_mask:0xf bank_mask:0xf
    v_and_or_b32 v24, v24, v3, s40
    v_and_or_b32 v25, v25, v3, s40
    s_cbranch_execz G_56
    buffer_store_dwordx2 v[24:25], v15, s[28:31], s46 offen sc1
    buffer_store_dwordx2 v[20:21], v7, s[28:31], s51 offen
G_56:
QWX:
    s_mov_b64 exec, -1
    s_branch KW
WPL:
    s_cmp_eq_u32 s52, 3
    s_cbranch_scc1 WIS
    s_cbranch_execz WIS
    global_load_dwordx4 v[32:35], v32, s[54:55]
    global_load_dwordx4 v[36:39], v36, s[54:55]
    global_load_dwordx4 v[40:43], v40, s[54:55]
    global_load_dwordx4 v[44:47], v44, s[54:55]
    global_load_dwordx4 v[48:51], v48, s[54:55]
    global_load_dwordx4 v[52:55], v52, s[54:55]
    global_load_dwordx4 v[56:59], v56, s[54:55]
    global_load_dwordx4 v[60:63], v60, s[54:55]
    s_branch WIS
LAR:
    s_mov_b64 exec, vcc
    buffer_load_dwordx4 v[28:31], v6, s[28:31], s58 offen sc1
    s_mov_b64 exec, s[34:35]
    s_waitcnt vmcnt(0)
    s_sub_u32 s50, s50, 1
    s_cbranch_scc0 LA
    s_branch LAX
    s_endpgm
.section .rodata,"a"
.p2align 6
.amdhsa_kernel sequential_preLN__gqa_block_cached__mixer_channel_mlp__decode_kernel
  .amdhsa_next_free_vgpr 128
  .amdhsa_next_free_sgpr 102
  .amdhsa_accum_offset 128
  .amdhsa_group_segment_fixed_size 0
  .amdhsa_kernarg_size 104
  .amdhsa_user_sgpr_count 2
  .amdhsa_user_sgpr_kernarg_segment_ptr 1
  .amdhsa_system_sgpr_workgroup_id_x 1
  .amdhsa_float_denorm_mode_32 3
.end_amdhsa_kernel
```
